```python
import torch

def _softmax(x, axis=-1):
    return torch.softmax(x, dim=axis)
def _gelu(x):
    return torch.nn.functional.gelu(x, approximate="tanh")
def _silu(x):
    return torch.nn.functional.silu(x)
def _sigmoid(x):
    return torch.sigmoid(x)
def _layernorm(x, axis=-1, eps=1e-5):
    m = x.mean(dim=axis, keepdim=True)
    v = x.var(dim=axis, keepdim=True, unbiased=False)
    return (x - m) / torch.sqrt(v + eps)
def _scatter_add(tgt, idx, src, axis=0):
    return tgt.clone().index_add_(axis, idx, src)
def _segment_sum(src, seg, n):
    out = torch.zeros((n,) + src.shape[1:], dtype=src.dtype)
    return out.index_add_(0, seg, src)
def _pad(x, pw):
    flat = tuple(v for pair in reversed(pw) for v in pair)
    return torch.nn.functional.pad(x, flat)

kernel_name = 'sequential_preLN__sliding_block_cached__dense_activation_relu__decode'

def setup_inputs():

    _w = (lambda a: (lambda t: t.to(torch.bfloat16) if t.is_floating_point() else t)(torch.as_tensor(a)))
    def _A_setup():
        B, Sq, D = 1, 1, 640
        Hq, Hkv, Sk, Dh = 32, 32, 4096, 128
        assert Hq % Hkv == 0, (Hq, Hkv)
        return {
            "x": _w((lambda *s: torch.randn(*s, dtype=torch.bfloat16) * 0.05)(B, Sq, D)),
            "k_cache": _w((lambda *s: torch.randn(*s, dtype=torch.bfloat16) * 3.2)(B, Hkv, Sk, Dh)),
            "v_cache": _w((lambda *s: torch.randn(*s, dtype=torch.bfloat16) * 0.4)(B, Hkv, Sk, Dh)),
            "wq": _w((lambda *s: torch.randn(*s, dtype=torch.bfloat16) * 3.2)(D, Hq * Dh) * (D ** -0.5)),
            "wo": _w((lambda *s: torch.randn(*s, dtype=torch.bfloat16) * 0.4)(Hq * Dh, D) * ((Hq * Dh) ** -0.5)),
        }
    _A_in = _A_setup()

    def _B_setup():
        B, S, D, Dff = 1, 1, 640, 1728
        return {
            "x": _w((lambda *s: torch.randn(*s, dtype=torch.bfloat16) * 0.05)(B, S, D)),
            "w1": _w((lambda *s: torch.randn(*s, dtype=torch.bfloat16) * 0.05)(D, Dff)),
            "w2": _w((lambda *s: torch.randn(*s, dtype=torch.bfloat16) * 0.05)(Dff, D)),
        }
    _B_in = _B_setup()

    return {
        "A_x": _A_in["x"],
        "A_k_cache": _A_in["k_cache"],
        "A_v_cache": _A_in["v_cache"],
        "A_wq": _A_in["wq"],
        "A_wo": _A_in["wo"],
        "B_x": _B_in["x"],
        "B_w1": _B_in["w1"],
        "B_w2": _B_in["w2"],
    }

def reference(A_x, A_k_cache, A_v_cache, A_wq, A_wo, B_x, B_w1, B_w2):
    def _A_ref(x, k_cache, v_cache, wq, wo):
        B, Sq, D = x.shape
        Hq, Dh = 32, 128
        Hkv, Sk = k_cache.shape[1], k_cache.shape[2]
        W = min(4096, max(256, Sk // 4))
        rep = Hq // Hkv
        q = (lambda x, *d: x.permute(*d))((x @ wq).reshape(B, Sq, Hq, Dh), 0, 2, 1, 3)
        k = (lambda x, n, axis: torch.repeat_interleave(x, n, dim=axis))(k_cache[:, :, Sk - W:, :], rep, axis=1)
        v = (lambda x, n, axis: torch.repeat_interleave(x, n, dim=axis))(v_cache[:, :, Sk - W:, :], rep, axis=1)
        scores = torch.einsum("bhqd,bhkd->bhqk", q, k) * (Dh ** -0.5)
        p = _softmax(scores, axis=-1)
        o = torch.einsum("bhqk,bhkd->bhqd", p, v)
        return (lambda x, *d: x.permute(*d))(o, 0, 2, 1, 3).reshape(B, Sq, Hq * Dh) @ wo

    def _B_ref(x, w1, w2):
        h = torch.einsum("bsd,df->bsf", x, w1)
        zero = torch.zeros_like(h)
        h = torch.maximum(h, zero)
        return torch.einsum("bsf,fd->bsd", h, w2)

    x = A_x
    h = x + _A_ref(_layernorm(x, axis=-1), A_k_cache, A_v_cache, A_wq, A_wo)
    h2 = h + _B_ref(_layernorm(h, axis=-1), B_w1, B_w2)
    return h2
```

```asm
; @launch grid=(256,1,1) block=(320,1,1) lds=54272
.amdgcn_target "amdgcn-amd-amdhsa--gfx950"
.text
.globl sequential_preLN__sliding_block_cached__dense_activation_relu__decode_kernel
.p2align 8
.type sequential_preLN__sliding_block_cached__dense_activation_relu__decode_kernel,@function
sequential_preLN__sliding_block_cached__dense_activation_relu__decode_kernel:
    s_cmp_ge_u32 s2, 256
    s_cbranch_scc1 L_end
    s_load_dwordx16 s[4:19], s[0:1], 0
    s_load_dwordx4 s[20:23], s[0:1], 64
    s_load_dwordx2 s[24:25], s[0:1], 80
    s_getpc_b64 s[34:35]
L_pc:
    v_lshlrev_b32 v9, 7, v0
    v_min_u32 v9, L_last-L_pc, v9
    s_mov_b32 s36, (L_last-L_pc+255)/128
    v_cmp_gt_u32 vcc, s36, v0
    s_and_saveexec_b64 s[36:37], vcc
    s_cbranch_execz L_nopf
    global_load_dword v31, v9, s[34:35]
L_nopf:
    s_mov_b64 exec, s[36:37]

    v_and_b32 v1, 63, v0
    v_lshrrev_b32 v9, 6, v0
    v_lshrrev_b32 v2, 4, v1
    v_and_b32 v3, 15, v0
    v_readfirstlane_b32 s31, v9
    s_and_b32 s26, s2, 7
    s_lshr_b32 s27, s2, 3
    s_and_b32 s33, s27, 3
    s_lshl_b32 s28, s26, 2
    s_add_u32 s28, s28, s33
    s_lshr_b32 s29, s27, 2
    s_mul_i32 s35, s29, 80
    s_lshl_b32 s34, s31, 4
    s_add_u32 s33, s35, s34
    v_lshl_add_u32 v9, v2, 2, s33
    v_lshlrev_b32 v9, 13, v9
    v_lshl_add_u32 v9, v3, 4, v9
    s_lshl_b32 s34, s28, 8
    v_add_u32 v20, s34, v9
    v_add_u32 v21, 0x2000, v20
    v_add_u32 v22, 0x4000, v20
    v_add_u32 v23, 0x6000, v20
    v_lshlrev_b32 v19, 4, v1
    s_sub_u32 s63, s31, 1
    s_cbranch_scc1 L_hpro
    s_lshl_b32 s33, s28, 20
    s_lshl_b32 s34, s29, 15
    s_add_u32 s33, s33, s34
    s_lshl_b32 s34, s63, 13
    s_add_u32 s33, s33, s34
    s_add_u32 s33, s33, 790528
    v_add_u32 v26, s33, v19
    v_lshrrev_b32 v25, 2, v3
    v_and_b32 v9, 2, v3
    v_lshl_add_u32 v25, v9, 1, v25
    v_lshlrev_b32 v25, 8, v25
    v_and_b32 v9, 1, v3
    v_lshlrev_b32 v18, 6, v9
    v_lshl_add_u32 v18, v2, 4, v18
    v_add3_u32 v25, v25, v18, s33
    s_waitcnt lgkmcnt(0)
    global_load_dwordx4 v[32:35], v20, s[10:11] nt
    global_load_dwordx4 v[36:39], v21, s[10:11] nt
    global_load_dwordx4 v[40:43], v22, s[10:11] nt
    global_load_dwordx4 v[44:47], v23, s[10:11] nt
    s_barrier
    global_load_dwordx4 v[80:83], v26, s[8:9] offset:-4096 nt
    global_load_dwordx4 v[84:87], v26, s[8:9] offset:-3072 nt
    global_load_dwordx4 v[88:91], v26, s[8:9] offset:-2048 nt
    global_load_dwordx4 v[92:95], v26, s[8:9] offset:-1024 nt
    s_branch L_com
L_hpro:
    v_lshlrev_b32 v24, 2, v1
    v_min_u32 v18, 19, v1
    s_lshl_b32 s35, s35, 1
    v_lshl_add_u32 v18, v18, 3, s35
    s_lshl_b32 s33, s28, 3
    s_add_u32 s33, s33, s29
    s_lshl_b32 s34, s33, 9
    s_add_u32 s34, s34, 65536
    v_lshl_add_u32 v25, v3, 5, s34
    v_add_u32 v9, 393216, v25
    s_nop 1
    v_mov_b32_dpp v25, v9 quad_perm:[0,1,2,3] row_mask:0x2 bank_mask:0xf
    s_lshl_b32 s34, s33, 7
    s_add_u32 s34, s34, 393216
    v_and_b32 v9, 3, v3
    v_lshl_add_u32 v9, v9, 5, s34
    s_nop 1
    v_mov_b32_dpp v25, v9 quad_perm:[0,1,2,3] row_mask:0xc bank_mask:0xf
    v_add_u32 v26, 0x1000, v19
    s_waitcnt lgkmcnt(0)
    global_load_dwordx4 v[10:13], v19, s[4:5]
    global_load_dword v14, v24, s[4:5] offset:1024
    global_load_dwordx2 v[16:17], v18, s[4:5]
    global_load_dwordx4 v[32:35], v20, s[10:11] nt
    global_load_dwordx4 v[36:39], v21, s[10:11] nt
    global_load_dwordx4 v[40:43], v22, s[10:11] nt
    global_load_dwordx4 v[44:47], v23, s[10:11] nt
    s_barrier
L_com:
    s_load_dword s32, s[24:25], 0
    s_lshl_b32 s30, s28, 3
    s_add_u32 s30, s30, s29
    s_mov_b32 s40, 0x07060500
    s_mov_b32 s41, 0x07060501
    s_mov_b32 s42, 0x07060502
    s_mov_b32 s43, 0x07060503
    s_mov_b32 s44, 0x0c0c0400
    s_mov_b32 s45, 0x04000c0c
    v_and_b32 v9, 1, v3
    v_lshlrev_b32 v9, 4, v9
    s_mov_b32 s33, 0xffff
    v_lshlrev_b32 v9, v9, s33
    v_lshrrev_b32 v15, 1, v3
    v_cmp_eq_u32 vcc, 0, v15
    s_nop 1
    v_cndmask_b32 v4, 0, v9, vcc
    v_cmp_eq_u32 vcc, 1, v15
    s_nop 1
    v_cndmask_b32 v5, 0, v9, vcc
    v_cmp_eq_u32 vcc, 2, v15
    s_nop 1
    v_cndmask_b32 v6, 0, v9, vcc
    v_cmp_eq_u32 vcc, 3, v15
    s_nop 1
    v_cndmask_b32 v7, 0, v9, vcc
    s_lshr_b32 s33, s27, 1
    s_lshl_b32 s33, s33, 3
    s_add_u32 s33, s33, s26
    s_lshl_b32 s34, s33, 1
    s_and_b32 s35, s27, 1
    s_add_u32 s34, s34, s35
    s_cmp_lt_u32 s33, 27
    s_cselect_b32 s46, 2, 0
    s_cselect_b32 s47, s34, 0
    s_sub_u32 s35, s27, 12
    s_cmp_ge_u32 s27, 12
    s_cselect_b32 s46, 1, s46
    s_cselect_b32 s47, s35, s47
    s_lshl_b32 s33, s26, 2
    s_add_u32 s33, s33, s63
    s_max_i32 s33, s33, 0
    s_cmp_eq_u32 s46, 2
    s_cselect_b32 s48, s16, s12
    s_cselect_b32 s49, s17, s13
    s_movk_i32 s51, 1280
    s_cselect_b32 s51, 3456, s51
    s_cselect_b32 s33, s31, s33
    s_lshl_b32 s33, s33, 7
    s_mul_i32 s33, s33, s51
    s_lshl_b32 s34, s47, 6
    s_add_u32 s33, s33, s34
    s_lshl_b32 s50, s51, 4
    v_lshrrev_b32 v27, 2, v1
    v_mul_lo_u32 v27, v27, s51
    v_and_b32 v9, 3, v1
    v_lshl_add_u32 v27, v9, 4, v27
    v_add_u32 v27, s33, v27
    s_cmp_lg_u32 s46, 0
    s_cselect_b64 s[52:53], -1, 0
    v_lshlrev_b32 v15, 5, v3
    v_lshl_add_u32 v15, v2, 4, v15
    s_lshl_b32 s33, s31, 9
    v_add_u32 v15, s33, v15
    s_lshl_b32 s33, s31, 6
    v_lshl_add_u32 v9, v2, 4, s33
    s_waitcnt lgkmcnt(0)
    s_add_u32 s32, s32, 0x9E3779B9
    v_mov_b32 v8, s32
    s_cmp_eq_u32 s31, 0
    s_cbranch_scc1 L_helper
    s_waitcnt vmcnt(7)
    global_load_dwordx4 v[48:51], v25, s[6:7] offset:-4096 nt
    s_waitcnt vmcnt(7)
    global_load_dwordx4 v[52:55], v25, s[6:7] offset:-3968 nt
    s_waitcnt vmcnt(7)
    global_load_dwordx4 v[56:59], v25, s[6:7] offset:-2048 nt
    s_waitcnt vmcnt(7)
    global_load_dwordx4 v[60:63], v25, s[6:7] offset:-1920 nt
    s_barrier
    ds_read_b128 v[10:13], v9 offset:5632
    s_waitcnt lgkmcnt(0)
    v_and_b32 v208, v10, v4
    v_and_b32 v209, v10, v5
    v_and_b32 v210, v10, v6
    v_and_b32 v211, v10, v7
    v_and_b32 v212, v11, v4
    v_and_b32 v213, v11, v5
    v_and_b32 v214, v11, v6
    v_and_b32 v215, v11, v7
    v_mfma_f32_16x16x32_bf16 v[192:195], v[208:211], v[32:35], 0
    v_and_b32 v216, v12, v4
    v_and_b32 v217, v12, v5
    v_and_b32 v218, v12, v6
    v_and_b32 v219, v12, v7
    v_mfma_f32_16x16x32_bf16 v[192:195], v[212:215], v[36:39], v[192:195]
    v_and_b32 v220, v13, v4
    v_and_b32 v221, v13, v5
    v_and_b32 v222, v13, v6
    v_and_b32 v223, v13, v7
    v_mfma_f32_16x16x32_bf16 v[192:195], v[216:219], v[40:43], v[192:195]
    s_nop 0
    v_mfma_f32_16x16x32_bf16 v[192:195], v[220:223], v[44:47], v[192:195]
    s_mov_b32 exec_hi, 0
    s_nop 6
    ds_write_b128 v15, v[192:195] offset:0
    s_mov_b32 exec_hi, -1
    s_waitcnt lgkmcnt(0)
    s_barrier
    s_barrier
    s_waitcnt vmcnt(7)
    global_load_dwordx4 v[64:67], v25, s[6:7] offset:0 nt
    s_waitcnt vmcnt(7)
    global_load_dwordx4 v[68:71], v25, s[6:7] offset:128 nt
    s_waitcnt vmcnt(7)
    global_load_dwordx4 v[72:75], v25, s[6:7] offset:2048 nt
    s_waitcnt vmcnt(7)
    global_load_dwordx4 v[76:79], v25, s[6:7] offset:2176 nt
    s_waitcnt vmcnt(7)
    global_load_dwordx4 v[96:99], v26, s[8:9] offset:0 nt
    s_waitcnt vmcnt(7)
    global_load_dwordx4 v[100:103], v26, s[8:9] offset:1024 nt
    s_waitcnt vmcnt(7)
    global_load_dwordx4 v[104:107], v26, s[8:9] offset:2048 nt
    s_waitcnt vmcnt(7)
    global_load_dwordx4 v[108:111], v26, s[8:9] offset:3072 nt
    s_waitcnt vmcnt(6)
    s_mov_b64 exec, s[52:53]
    global_load_dwordx4 v[112:115], v27, s[48:49] nt
    v_add_u32 v27, s50, v27
    s_mov_b64 exec, -1
    s_waitcnt vmcnt(6)
    s_mov_b64 exec, s[52:53]
    global_load_dwordx4 v[116:119], v27, s[48:49] nt
    v_add_u32 v27, s50, v27
    s_mov_b64 exec, -1
    s_waitcnt vmcnt(6)
    s_mov_b64 exec, s[52:53]
    global_load_dwordx4 v[120:123], v27, s[48:49] nt
    v_add_u32 v27, s50, v27
    s_mov_b64 exec, -1
    s_waitcnt vmcnt(6)
    s_mov_b64 exec, s[52:53]
    global_load_dwordx4 v[124:127], v27, s[48:49] nt
    v_add_u32 v27, s50, v27
    s_mov_b64 exec, -1
    s_waitcnt vmcnt(6)
    s_mov_b64 exec, s[52:53]
    global_load_dwordx4 v[128:131], v27, s[48:49] nt
    v_add_u32 v27, s50, v27
    s_mov_b64 exec, -1
    s_mov_b32 s54, 0xaaaaaaaa
    s_mov_b32 s55, 0xaaaaaaaa
    s_mov_b32 vcc_lo, 0xcccccccc
    s_mov_b32 vcc_hi, 0xcccccccc
    s_lshl_b32 s33, s63, 3
    v_mov_b32 v9, s33
    s_barrier
    ds_read_b128 v[32:35], v18 offset:2560
    ds_read_b128 v[36:39], v18 offset:2688
    s_waitcnt vmcnt(15) lgkmcnt(0)
    v_mfma_f32_16x16x32_bf16 v[176:179], v[48:51], v[32:35], 0
    v_mfma_f32_16x16x32_bf16 v[176:179], v[52:55], v[36:39], v[176:179]
    s_waitcnt vmcnt(13)
    v_mfma_f32_16x16x32_bf16 v[180:183], v[56:59], v[32:35], 0
    v_mfma_f32_16x16x32_bf16 v[180:183], v[60:63], v[36:39], v[180:183]
    s_waitcnt vmcnt(11)
    v_mfma_f32_16x16x32_bf16 v[184:187], v[64:67], v[32:35], 0
    v_mfma_f32_16x16x32_bf16 v[184:187], v[68:71], v[36:39], v[184:187]
    s_waitcnt vmcnt(9)
    v_mfma_f32_16x16x32_bf16 v[188:191], v[72:75], v[32:35], 0
    v_mfma_f32_16x16x32_bf16 v[188:191], v[76:79], v[36:39], v[188:191]
    v_cndmask_b32 v12, v176, v177, s[54:55]
    v_cndmask_b32 v13, v178, v179, s[54:55]
    s_nop 1
    v_cndmask_b32_dpp v14, v12, v13, vcc quad_perm:[0,1,2,3] row_mask:0xf bank_mask:1
    v_cndmask_b32 v12, v180, v181, s[54:55]
    v_cndmask_b32 v13, v182, v183, s[54:55]
    s_nop 1
    v_cndmask_b32_dpp v14, v12, v13, vcc quad_perm:[0,1,2,3] row_mask:0xf bank_mask:2
    v_cndmask_b32 v12, v184, v185, s[54:55]
    v_cndmask_b32 v13, v186, v187, s[54:55]
    s_nop 1
    v_cndmask_b32_dpp v14, v12, v13, vcc quad_perm:[0,1,2,3] row_mask:0xf bank_mask:4
    v_cndmask_b32 v12, v188, v189, s[54:55]
    v_cndmask_b32 v13, v190, v191, s[54:55]
    s_nop 1
    v_cndmask_b32_dpp v14, v12, v13, vcc quad_perm:[0,1,2,3] row_mask:0xf bank_mask:8
    s_nop 1
    v_add_f32_dpp v14, v14, v14 quad_perm:[1,0,3,2] row_mask:0xf bank_mask:0xf
    v_cvt_pk_bf16_f32 v14, v14, v14
    v_lshlrev_b32 v14, 16, v14
    v_mul_f32 v14, 0x3db504f3, v14
    v_cvt_pk_bf16_f32 v14, v14, v14
    v_lshlrev_b32 v14, 16, v14
    s_nop 1
    v_max_f32_dpp v10, v14, v14 row_ror:2 row_mask:0xf bank_mask:0xf
    s_nop 1
    v_max_f32_dpp v10, v10, v10 row_ror:4 row_mask:0xf bank_mask:0xf
    s_nop 1
    v_max_f32_dpp v10, v10, v10 row_ror:8 row_mask:0xf bank_mask:0xf
    v_mov_b32 v12, v10
    s_nop 1
    v_permlane16_swap_b32 v10, v12
    v_max_f32 v10, v10, v12
    v_mov_b32 v12, v10
    s_nop 1
    v_permlane32_swap_b32 v10, v12
    v_max_f32 v10, v10, v12
    v_sub_f32 v14, v14, v10

    v_mul_f32 v14, 0x3fb8aa3b, v14
    v_exp_f32 v11, v14
    s_nop 0
    v_cvt_pk_bf16_f32 v14, v11, v11
    v_add_f32_dpp v11, v11, v11 row_ror:2 row_mask:0xf bank_mask:0xf
    s_nop 0
    v_and_b32_dpp v48, v14, v4 row_newbcast:0 row_mask:0xf bank_mask:0xf
    v_and_b32_dpp v49, v14, v5 row_newbcast:0 row_mask:0xf bank_mask:0xf
    v_and_b32_dpp v50, v14, v6 row_newbcast:0 row_mask:0xf bank_mask:0xf
    v_and_b32_dpp v51, v14, v7 row_newbcast:0 row_mask:0xf bank_mask:0xf
    v_add_f32_dpp v11, v11, v11 row_ror:4 row_mask:0xf bank_mask:0xf
    v_and_b32_dpp v52, v14, v4 row_newbcast:2 row_mask:0xf bank_mask:0xf
    v_and_b32_dpp v53, v14, v5 row_newbcast:2 row_mask:0xf bank_mask:0xf
    v_and_b32_dpp v54, v14, v6 row_newbcast:2 row_mask:0xf bank_mask:0xf
    v_and_b32_dpp v55, v14, v7 row_newbcast:2 row_mask:0xf bank_mask:0xf
    v_mfma_f32_16x16x32_bf16 v[192:195], v[48:51], v[80:83], 0
    v_add_f32_dpp v11, v11, v11 row_ror:8 row_mask:0xf bank_mask:0xf
    v_mov_b32 v12, v11
    v_and_b32_dpp v56, v14, v4 row_newbcast:4 row_mask:0xf bank_mask:0xf
    v_and_b32_dpp v57, v14, v5 row_newbcast:4 row_mask:0xf bank_mask:0xf
    v_and_b32_dpp v58, v14, v6 row_newbcast:4 row_mask:0xf bank_mask:0xf
    v_and_b32_dpp v59, v14, v7 row_newbcast:4 row_mask:0xf bank_mask:0xf
    v_mfma_f32_16x16x32_bf16 v[192:195], v[52:55], v[84:87], v[192:195]
    v_permlane16_swap_b32 v11, v12
    v_add_f32 v11, v11, v12
    v_mov_b32 v12, v11
    v_and_b32_dpp v60, v14, v4 row_newbcast:6 row_mask:0xf bank_mask:0xf
    v_and_b32_dpp v61, v14, v5 row_newbcast:6 row_mask:0xf bank_mask:0xf
    v_and_b32_dpp v62, v14, v6 row_newbcast:6 row_mask:0xf bank_mask:0xf
    v_and_b32_dpp v63, v14, v7 row_newbcast:6 row_mask:0xf bank_mask:0xf
    v_mfma_f32_16x16x32_bf16 v[192:195], v[56:59], v[88:91], v[192:195]
    v_permlane32_swap_b32 v11, v12
    v_add_f32 v11, v11, v12
    s_mov_b64 exec, 1
    ds_write_b64 v9, v[10:11] offset:2816
    s_mov_b64 exec, -1
    v_and_b32_dpp v64, v14, v4 row_newbcast:8 row_mask:0xf bank_mask:0xf
    v_and_b32_dpp v65, v14, v5 row_newbcast:8 row_mask:0xf bank_mask:0xf
    v_and_b32_dpp v66, v14, v6 row_newbcast:8 row_mask:0xf bank_mask:0xf
    v_and_b32_dpp v67, v14, v7 row_newbcast:8 row_mask:0xf bank_mask:0xf
    v_mfma_f32_16x16x32_bf16 v[192:195], v[60:63], v[92:95], v[192:195]
    v_and_b32_dpp v68, v14, v4 row_newbcast:10 row_mask:0xf bank_mask:0xf
    v_and_b32_dpp v69, v14, v5 row_newbcast:10 row_mask:0xf bank_mask:0xf
    v_and_b32_dpp v70, v14, v6 row_newbcast:10 row_mask:0xf bank_mask:0xf
    v_and_b32_dpp v71, v14, v7 row_newbcast:10 row_mask:0xf bank_mask:0xf
    v_and_b32_dpp v72, v14, v4 row_newbcast:12 row_mask:0xf bank_mask:0xf
    v_and_b32_dpp v73, v14, v5 row_newbcast:12 row_mask:0xf bank_mask:0xf
    v_and_b32_dpp v74, v14, v6 row_newbcast:12 row_mask:0xf bank_mask:0xf
    v_and_b32_dpp v75, v14, v7 row_newbcast:12 row_mask:0xf bank_mask:0xf
    v_and_b32_dpp v76, v14, v4 row_newbcast:14 row_mask:0xf bank_mask:0xf
    v_and_b32_dpp v77, v14, v5 row_newbcast:14 row_mask:0xf bank_mask:0xf
    v_and_b32_dpp v78, v14, v6 row_newbcast:14 row_mask:0xf bank_mask:0xf
    v_and_b32_dpp v79, v14, v7 row_newbcast:14 row_mask:0xf bank_mask:0xf
    s_waitcnt lgkmcnt(0)
    s_barrier
    s_waitcnt vmcnt(8)
    v_mfma_f32_16x16x32_bf16 v[192:195], v[64:67], v[96:99], v[192:195]
    s_waitcnt vmcnt(7)
    v_mfma_f32_16x16x32_bf16 v[192:195], v[68:71], v[100:103], v[192:195]
    s_waitcnt vmcnt(6)
    v_mfma_f32_16x16x32_bf16 v[192:195], v[72:75], v[104:107], v[192:195]
    s_waitcnt vmcnt(5)
    v_mfma_f32_16x16x32_bf16 v[192:195], v[76:79], v[108:111], v[192:195]
    s_mov_b32 exec_hi, 0
    s_nop 6
    ds_write_b128 v15, v[192:195] offset:2560
    s_mov_b32 exec_hi, -1
    s_waitcnt lgkmcnt(0)
    s_barrier
    s_barrier
    s_mov_b64 exec, s[52:53]
    global_load_dwordx4 v[132:135], v27, s[48:49] nt
    v_add_u32 v27, s50, v27
    global_load_dwordx4 v[136:139], v27, s[48:49] nt
    v_add_u32 v27, s50, v27
    global_load_dwordx4 v[140:143], v27, s[48:49] nt
    s_mov_b64 exec, -1
    s_cmp_eq_u32 s46, 2
    s_cbranch_scc1 L_ffn
    s_cmp_lg_u32 s46, 1
    s_cbranch_scc1 L_fin
    s_mul_i32 s33, s31, 9216
    s_add_u32 s33, s33, 8192
    v_and_b32 v24, 1, v2
    v_lshlrev_b32 v24, 5, v24
    v_xor_b32 v20, v19, v24
    v_add_u32 v20, s33, v20
    v_lshrrev_b32 v25, 2, v3
    v_and_b32 v9, 3, v3
    v_lshlrev_b32 v22, 8, v2
    v_lshl_add_u32 v22, v25, 6, v22
    v_lshl_add_u32 v22, v9, 3, v22
    v_add3_u32 v22, v22, v24, s33
    v_xor_b32 v23, 32, v22
    s_lshl_b32 s33, s26, 2
    s_add_u32 s33, s33, s63
    s_lshl_b32 s34, s33, 10
    s_add_u32 s34, s34, 393216
    v_lshl_add_u32 v26, v25, 8, s34
    v_lshl_add_u32 v26, v24, 2, v26
    s_lshl_b32 s34, s33, 12
    s_add_u32 s34, s34, 458752
    v_lshlrev_b32 v27, 6, v2
    v_lshl_add_u32 v27, v9, 4, v27
    v_lshl_add_u32 v27, v25, 10, v27
    v_add_u32 v27, s34, v27
    v_lshl_add_u32 v19, s63, 6, v1
    v_lshlrev_b32 v19, 2, v19

    s_mov_b32 s62, 32768
    s_waitcnt vmcnt(7)
    ds_write_b128 v20, v[112:115] offset:0
    ds_read_b64_tr_b16 v[144:145], v22 offset:0
    ds_read_b64_tr_b16 v[160:161], v23 offset:0
    s_waitcnt vmcnt(6)
    ds_write_b128 v20, v[116:119] offset:1024
    ds_read_b64_tr_b16 v[146:147], v22 offset:1024
    ds_read_b64_tr_b16 v[162:163], v23 offset:1024
    s_waitcnt vmcnt(5)
    ds_write_b128 v20, v[120:123] offset:2048
    ds_read_b64_tr_b16 v[148:149], v22 offset:2048
    ds_read_b64_tr_b16 v[164:165], v23 offset:2048
    s_waitcnt vmcnt(4)
    ds_write_b128 v20, v[124:127] offset:3072
    ds_read_b64_tr_b16 v[150:151], v22 offset:3072
    ds_read_b64_tr_b16 v[166:167], v23 offset:3072
    s_waitcnt vmcnt(3)
    ds_write_b128 v20, v[128:131] offset:4096
    ds_read_b64_tr_b16 v[152:153], v22 offset:4096
    ds_read_b64_tr_b16 v[168:169], v23 offset:4096
    global_load_dwordx4 v[80:83], v26, s[24:25] sc1
    global_load_dwordx4 v[32:35], v27, s[24:25] offset:0 sc1
    global_load_dwordx4 v[36:39], v27, s[24:25] offset:256 sc1
    global_load_dwordx4 v[40:43], v27, s[24:25] offset:512 sc1
    global_load_dwordx4 v[44:47], v27, s[24:25] offset:768 sc1
    s_waitcnt vmcnt(7)
    ds_write_b128 v20, v[132:135] offset:5120
    ds_read_b64_tr_b16 v[154:155], v22 offset:5120
    ds_read_b64_tr_b16 v[170:171], v23 offset:5120
    s_waitcnt vmcnt(6)
    ds_write_b128 v20, v[136:139] offset:6144
    ds_read_b64_tr_b16 v[156:157], v22 offset:6144
    ds_read_b64_tr_b16 v[172:173], v23 offset:6144
    s_waitcnt vmcnt(5)
    ds_write_b128 v20, v[140:143] offset:7168
    ds_read_b64_tr_b16 v[158:159], v22 offset:7168
    ds_read_b64_tr_b16 v[174:175], v23 offset:7168
L_or:
    s_waitcnt vmcnt(4)
    v_bitop3_b32 v30, v80, v82, v8 bitop3:0x96
    v_bitop3_b32 v31, v81, v83, v8 bitop3:0x96
    v_mov_b32 v84, v80
    v_mov_b32 v85, v80
    v_mov_b32 v86, v81
    v_mov_b32 v87, v81
    v_permlane16_swap_b32 v84, v85
    v_or_b32 v30, v30, v31
    v_max_f32 v10, v84, v85
    v_cmp_ne_u32 s[48:49], 0, v30
    v_permlane16_swap_b32 v86, v87
    v_max_f32_dpp v10, v10, v10 row_ror:4 row_mask:0xf bank_mask:0xf
    s_waitcnt vmcnt(3)
    v_perm_b32 v16, v33, v32, s44
    v_perm_b32 v17, v35, v34, s45
    v_max_f32_dpp v10, v10, v10 row_ror:8 row_mask:0xf bank_mask:0xf
    v_sub_f32 v12, v84, v10
    v_sub_f32 v14, v85, v10
    v_mul_f32 v12, 0x3fb8aa3b, v12
    v_mul_f32 v14, 0x3fb8aa3b, v14
    v_exp_f32 v12, v12
    v_exp_f32 v14, v14
    v_or_b32 v16, v16, v17
    v_cmp_ne_u32 s[54:55], v16, v8
    s_waitcnt vmcnt(2)
    v_perm_b32 v28, v37, v36, s44
    v_perm_b32 v29, v39, v38, s45
    v_or_b32 v28, v28, v29
    v_cmp_ne_u32 s[56:57], v28, v8
    s_or_b64 s[34:35], s[48:49], s[54:55]
    s_waitcnt vmcnt(1)
    v_perm_b32 v16, v41, v40, s44
    v_perm_b32 v17, v43, v42, s45
    v_or_b32 v16, v16, v17
    v_cmp_ne_u32 s[58:59], v16, v8
    s_or_b64 s[34:35], s[34:35], s[56:57]
    s_waitcnt vmcnt(0)
    v_perm_b32 v28, v45, v44, s44
    v_perm_b32 v29, v47, v46, s45
    v_or_b32 v28, v28, v29
    v_cmp_ne_u32 s[60:61], v28, v8
    s_or_b64 s[34:35], s[34:35], s[58:59]
    v_pk_mul_f32 v[48:49], v[32:33], v[12:13] op_sel_hi:[1,0]
    v_pk_mul_f32 v[50:51], v[34:35], v[12:13] op_sel_hi:[1,0]
    s_or_b64 s[34:35], s[34:35], s[60:61]
    s_cbranch_scc0 L_or_d
    s_cmp_eq_u32 s62, 32720
    s_cselect_b32 s33, 3145728, 0
    v_add_u32 v26, s33, v26
    v_add_u32 v27, s33, v27
    s_mov_b64 exec, s[48:49]
    global_load_dwordx4 v[80:83], v26, s[24:25] sc1
    s_mov_b64 exec, s[54:55]
    global_load_dwordx4 v[32:35], v27, s[24:25] offset:0 sc1
    s_mov_b64 exec, s[56:57]
    global_load_dwordx4 v[36:39], v27, s[24:25] offset:256 sc1
    s_mov_b64 exec, s[58:59]
    global_load_dwordx4 v[40:43], v27, s[24:25] offset:512 sc1
    s_mov_b64 exec, s[60:61]
    global_load_dwordx4 v[44:47], v27, s[24:25] offset:768 sc1
    s_mov_b64 exec, -1
    s_sub_u32 s62, s62, 1
    s_cbranch_scc0 L_or
L_or_d:
    v_pk_mul_f32 v[52:53], v[36:37], v[12:13] op_sel_hi:[1,0]
    v_pk_mul_f32 v[54:55], v[38:39], v[12:13] op_sel_hi:[1,0]
    v_pk_fma_f32 v[48:49], v[40:41], v[14:15], v[48:49] op_sel_hi:[1,0,1]
    v_pk_fma_f32 v[50:51], v[42:43], v[14:15], v[50:51] op_sel_hi:[1,0,1]
    v_pk_fma_f32 v[52:53], v[44:45], v[14:15], v[52:53] op_sel_hi:[1,0,1]
    v_pk_fma_f32 v[54:55], v[46:47], v[14:15], v[54:55] op_sel_hi:[1,0,1]
    v_cvt_pk_bf16_f32 v56, v48, v49
    v_cvt_pk_bf16_f32 v57, v50, v51
    v_cvt_pk_bf16_f32 v58, v52, v53
    v_cvt_pk_bf16_f32 v59, v54, v55
    v_mul_f32 v11, v12, v86
    s_waitcnt lgkmcnt(0)
    v_mfma_f32_16x16x32_bf16 v[176:179], v[56:59], v[144:147], 0
    v_fma_f32 v11, v14, v87, v11
    v_mfma_f32_16x16x32_bf16 v[180:183], v[56:59], v[148:151], 0
    v_mfma_f32_16x16x32_bf16 v[184:187], v[56:59], v[152:155], 0
    v_add_f32_dpp v11, v11, v11 row_ror:4 row_mask:0xf bank_mask:0xf
    v_mfma_f32_16x16x32_bf16 v[188:191], v[56:59], v[156:159], 0
    v_mfma_f32_16x16x32_bf16 v[192:195], v[56:59], v[160:163], 0
    v_add_f32_dpp v11, v11, v11 row_ror:8 row_mask:0xf bank_mask:0xf
    v_mfma_f32_16x16x32_bf16 v[196:199], v[56:59], v[164:167], 0
    v_rcp_f32 v11, v11
    v_mfma_f32_16x16x32_bf16 v[200:203], v[56:59], v[168:171], 0
    v_add_f32 v10, v176, v181
    v_mfma_f32_16x16x32_bf16 v[204:207], v[56:59], v[172:175], 0
    s_nop 0
    v_add_f32 v12, v186, v191
    v_add_f32 v10, v10, v12
    s_nop 0
    v_add_f32 v13, v192, v197
    s_nop 2
    v_add_f32 v14, v202, v207
    v_add_f32 v13, v13, v14
    s_nop 1
    v_permlane16_swap_b32 v10, v13
    v_add_f32 v10, v10, v13
    v_mul_f32 v10, v10, v11
    ds_write_b32 v19, v10 offset:0
    s_waitcnt lgkmcnt(0)

    s_barrier
    s_cmp_lg_u32 s31, 1
    s_cbranch_scc1 L_fin
    s_mul_i32 s33, s26, 20
    s_add_u32 s33, s33, s47
    s_lshr_b32 s34, s33, 4
    s_lshl_b32 s34, s34, 6
    s_and_b32 s35, s33, 15
    s_add_u32 s34, s34, s35
    v_lshl_add_u32 v20, v2, 4, s34
    v_lshlrev_b32 v21, 1, v20
    global_load_ushort v16, v21, s[4:5]
    v_and_b32 v9, 7, v3
    v_mul_u32_u24 v22, 2560, v9
    v_lshrrev_b32 v20, 2, v20
    v_lshl_add_u32 v22, v20, 4, v22
    v_add_u32 v22, 1114112, v22
    v_add_u32 v24, 32768, v22
    v_cmp_eq_u32 vcc, s26, v9
    s_nop 1
    v_cndmask_b32 v22, v22, v24, vcc
    s_lshl_b32 s34, s33, 4
    s_add_u32 s34, s34, 4194304
    s_and_b32 s38, s33, 3
    s_mov_b32 s39, s33
    global_load_dwordx4 v[32:35], v22, s[24:25] sc1
    v_min_u32 v12, 53, v1
    v_bfe_u32 v9, v12, 1, 3
    v_mul_u32_u24 v12, 2560, v12
    v_add_u32 v12, s34, v12
    v_add_u32 v13, 1048576, v12
    v_cmp_eq_u32 vcc, s26, v9
    s_nop 1
    v_cndmask_b32 v12, v12, v13, vcc
    s_lshr_b32 s35, s33, 5
    s_lshl_b32 s35, s35, 4
    s_add_u32 s35, s35, 5242880
    v_lshl_add_u32 v17, v1, 7, s35
    s_mov_b32 s48, vcc_lo
    s_and_b32 s49, vcc_hi, 0x3fffff
    s_not_b32 s50, s48
    s_xor_b32 s51, s49, 0x3fffff
    v_add_u32 v13, 147456, v12
    v_add_u32 v14, 294912, v12
    v_add_u32 v15, 442368, v12
    v_mov_b32 v48, 0
    v_mov_b32 v49, 0
    v_mov_b32 v50, 0
    v_mov_b32 v51, 0
    v_mov_b32 v52, 0
    v_mov_b32 v53, 0
    v_mov_b32 v54, 0
    v_mov_b32 v55, 0
    v_mov_b32 v56, 0
    v_mov_b32 v57, 0
    v_mov_b32 v58, 0
    v_mov_b32 v59, 0
    v_mov_b32 v60, 0
    v_mov_b32 v61, 0
    v_mov_b32 v62, 0
    v_mov_b32 v63, 0
    s_mov_b32 s62, 32768
L_rw:
    s_waitcnt vmcnt(0)
    v_perm_b32 v28, v33, v32, s44
    v_perm_b32 v29, v35, v34, s45
    v_or_b32 v28, v28, v29
    v_cmp_ne_u32 s[54:55], v28, v8
    s_cmp_lg_u64 s[54:55], 0
    s_cbranch_scc0 L_rw_ok0
    s_mov_b64 exec, s[54:55]
    global_load_dwordx4 v[32:35], v22, s[24:25] sc1
    s_mov_b64 exec, -1
    s_cmp_gt_u32 s62, 32720
    s_cselect_b32 s33, -1, 4294934527
    v_and_b32 v22, s33, v22
    s_sub_u32 s62, s62, 1
    s_cbranch_scc0 L_rw
L_rw_ok0:
    s_mov_b32 s52, -1
    s_mov_b32 s53, 0x3fffff
    s_cmp_eq_u32 s38, 1
    s_cselect_b64 vcc, -1, 0
    v_cndmask_b32 v10, v32, v33, vcc
    s_cmp_eq_u32 s38, 2
    s_cselect_b64 vcc, -1, 0
    v_cndmask_b32 v10, v10, v34, vcc
    s_cmp_eq_u32 s38, 3
    s_cselect_b64 vcc, -1, 0
    v_cndmask_b32 v10, v10, v35, vcc
    s_nop 1
    v_add_f32_dpp v10, v10, v10 row_ror:1 row_mask:0xf bank_mask:0xf
    s_nop 1
    v_add_f32_dpp v10, v10, v10 row_ror:2 row_mask:0xf bank_mask:0xf
    s_nop 1
    v_add_f32_dpp v10, v10, v10 row_ror:4 row_mask:0xf bank_mask:0xf
    v_cvt_pk_bf16_f32 v10, v10, v10
    v_lshlrev_b32 v10, 16, v10
    v_lshlrev_b32 v16, 16, v16
    v_add_f32 v10, v10, v16
    v_cvt_pk_bf16_f32 v10, v10, v10
    v_lshlrev_b32 v10, 16, v10
    s_mov_b64 exec, s[52:53]
    s_mov_b64 exec, s[48:49]
    global_load_dwordx4 v[48:51], v12, s[24:25] sc1
    s_sleep 3
    global_load_dwordx4 v[48:51], v12, s[24:25] sc1
    s_sleep 3
    global_load_dwordx4 v[48:51], v12, s[24:25] sc1
    s_mov_b32 s62, 32768
L_rl:
    s_waitcnt vmcnt(2)
    s_cmp_gt_u32 s62, 32480
    s_cbranch_scc1 L_rl1
    s_waitcnt vmcnt(0)
    v_and_b32 v12, 4293918719, v12
L_rl1:

    v_perm_b32 v28, v49, v48, s44
    v_perm_b32 v29, v51, v50, s45
    v_or_b32 v28, v28, v29
    v_cmp_ne_u32 vcc, v28, v8
    s_cbranch_vccz L_rl_ok0
    s_mov_b64 exec, vcc
    global_load_dwordx4 v[48:51], v12, s[24:25] sc1
    s_mov_b64 exec, s[48:49]

    s_sub_u32 s62, s62, 1
    s_cbranch_scc0 L_rl

L_rl_ok0:
    s_mov_b64 exec, s[50:51]
    global_load_dwordx4 v[48:51], v12, s[24:25] sc1
    s_mov_b32 s62, 32768
L_rf:
    s_waitcnt vmcnt(0)
    v_perm_b32 v28, v49, v48, s44
    v_perm_b32 v29, v51, v50, s45
    v_or_b32 v28, v28, v29
    v_cmp_ne_u32 s[54:55], v28, v8
    s_cmp_lg_u64 s[54:55], 0
    s_cbranch_scc0 L_rf_ok0
    s_mov_b64 exec, s[54:55]
    global_load_dwordx4 v[48:51], v12, s[24:25] sc1
    s_mov_b64 exec, s[50:51]
    s_cmp_gt_u32 s62, 32720
    s_cselect_b32 s33, -1, 4293918719
    v_and_b32 v12, s33, v12
    s_sub_u32 s62, s62, 1
    s_cbranch_scc0 L_rf
L_rf_ok0:
    s_mov_b64 exec, -1
    v_permlane32_swap_b32 v48, v50
    v_permlane32_swap_b32 v49, v51
    v_pk_add_f32 v[36:37], v[48:49], v[50:51]
L_fd:
    s_nop 1
    v_permlane16_swap_b32 v36, v37
    v_add_f32 v11, v36, v37
    s_nop 1
    v_add_f32_dpp v11, v11, v11 row_ror:1 row_mask:0xf bank_mask:0xf
    s_nop 1
    v_add_f32_dpp v11, v11, v11 row_ror:2 row_mask:0xf bank_mask:0xf
    s_nop 1
    v_add_f32_dpp v11, v11, v11 row_ror:4 row_mask:0xf bank_mask:0xf
    s_nop 1
    v_add_f32_dpp v11, v11, v11 row_ror:8 row_mask:0xf bank_mask:0xf
    v_cvt_pk_bf16_f32 v11, v11, v11
    v_lshlrev_b32 v11, 16, v11
    v_add_f32 v11, v11, v10
    v_cvt_pk_bf16_f32 v11, v11, v11

    s_mov_b32 exec_lo, 0x00010001
    s_mov_b32 exec_hi, 0x00010001
    global_store_short v21, v11, s[20:21]
    s_cmp_lg_u32 s39, 0
    s_cbranch_scc1 L_fin
    s_mov_b64 exec, 1
    v_mov_b32 v9, 0
    global_store_dword v9, v8, s[24:25] sc1
    s_branch L_fin
L_helper:
    v_mov_b32 v28, 0
    v_mov_b32 v29, 0
    v_lshlrev_b32 v26, 3, v1
    ds_write_b64 v26, v[28:29] offset:5120
    s_waitcnt vmcnt(4)
    v_lshlrev_b32 v176, 16, v10
    v_and_b32 v177, 0xffff0000, v10
    v_lshlrev_b32 v178, 16, v11
    v_and_b32 v179, 0xffff0000, v11
    v_lshlrev_b32 v180, 16, v12
    v_and_b32 v181, 0xffff0000, v12
    v_lshlrev_b32 v182, 16, v13
    v_and_b32 v183, 0xffff0000, v13
    v_lshlrev_b32 v184, 16, v14
    v_and_b32 v185, 0xffff0000, v14
    v_pk_add_f32 v[10:11], v[176:177], v[178:179]
    v_pk_mul_f32 v[12:13], v[176:177], v[176:177]
    v_pk_fma_f32 v[12:13], v[178:179], v[178:179], v[12:13]
    v_pk_add_f32 v[10:11], v[10:11], v[180:181]
    v_pk_fma_f32 v[12:13], v[180:181], v[180:181], v[12:13]
    v_pk_add_f32 v[10:11], v[10:11], v[182:183]
    v_pk_fma_f32 v[12:13], v[182:183], v[182:183], v[12:13]
    v_pk_add_f32 v[10:11], v[10:11], v[184:185]
    v_pk_fma_f32 v[12:13], v[184:185], v[184:185], v[12:13]
    v_add_f32 v10, v10, v11
    v_add_f32 v12, v12, v13
    v_lshlrev_b32 v176, 16, v16
    v_add_f32_dpp v10, v10, v10 row_ror:1 row_mask:0xf bank_mask:0xf
    v_add_f32_dpp v12, v12, v12 row_ror:1 row_mask:0xf bank_mask:0xf
    v_and_b32 v177, 0xffff0000, v16
    v_add_f32_dpp v10, v10, v10 row_ror:2 row_mask:0xf bank_mask:0xf
    v_add_f32_dpp v12, v12, v12 row_ror:2 row_mask:0xf bank_mask:0xf
    v_lshlrev_b32 v178, 16, v17
    v_add_f32_dpp v10, v10, v10 row_ror:4 row_mask:0xf bank_mask:0xf
    v_add_f32_dpp v12, v12, v12 row_ror:4 row_mask:0xf bank_mask:0xf
    v_and_b32 v179, 0xffff0000, v17
    v_add_f32_dpp v10, v10, v10 row_ror:8 row_mask:0xf bank_mask:0xf
    v_add_f32_dpp v12, v12, v12 row_ror:8 row_mask:0xf bank_mask:0xf
    v_mov_b32 v11, v10
    v_mov_b32 v13, v12
    s_nop 0
    v_permlane16_swap_b32 v10, v11
    v_permlane16_swap_b32 v12, v13
    v_add_f32 v10, v10, v11
    v_add_f32 v12, v12, v13
    v_mov_b32 v11, v10
    v_mov_b32 v13, v12
    s_nop 0
    v_permlane32_swap_b32 v10, v11
    v_permlane32_swap_b32 v12, v13
    v_add_f32 v10, v10, v11
    v_add_f32 v12, v12, v13
    v_mul_f32 v10, 0x3acccccd, v10
    v_mul_f32 v12, 0x3acccccd, v12
    v_fma_f32 v12, -v10, v10, v12
    v_max_f32 v12, 0, v12
    v_cvt_pk_bf16_f32 v11, v10, v12
    v_and_b32 v13, 0xffff0000, v11
    v_add_f32 v13, 0x3727c5ac, v13
    v_cvt_pk_bf16_f32 v13, v13, v13
    v_lshlrev_b32 v13, 16, v13
    v_sqrt_f32 v13, v13
    v_lshlrev_b32 v11, 16, v11
    v_cvt_pk_bf16_f32 v13, v13, v13
    v_lshlrev_b32 v13, 16, v13
    v_rcp_f32 v14, v13

    v_sub_f32 v176, v176, v11
    v_sub_f32 v177, v177, v11
    v_sub_f32 v178, v178, v11
    v_sub_f32 v179, v179, v11
    v_cvt_pk_bf16_f32 v16, v176, v177
    v_cvt_pk_bf16_f32 v17, v178, v179
    v_lshlrev_b32 v176, 16, v16
    v_and_b32 v177, 0xffff0000, v16
    v_lshlrev_b32 v178, 16, v17
    v_and_b32 v179, 0xffff0000, v17
    v_mul_f32 v180, v176, v14
    v_mul_f32 v181, v177, v14
    v_mul_f32 v182, v178, v14
    v_mul_f32 v183, v179, v14
    v_fma_f32 v176, -v180, v13, v176
    v_fma_f32 v177, -v181, v13, v177
    v_fma_f32 v178, -v182, v13, v178
    v_fma_f32 v179, -v183, v13, v179
    v_fma_f32 v180, v176, v14, v180
    v_fma_f32 v181, v177, v14, v181
    v_fma_f32 v182, v178, v14, v182
    v_fma_f32 v183, v179, v14, v183
    v_cvt_pk_bf16_f32 v176, v180, v180
    v_cvt_pk_bf16_f32 v177, v181, v181
    v_cvt_pk_bf16_f32 v178, v182, v182
    v_cvt_pk_bf16_f32 v179, v183, v183
    s_mov_b64 exec, 0xfffff
    ds_write_b128 v19, v[176:179] offset:5632
    s_mov_b64 exec, -1
    s_waitcnt vmcnt(0) lgkmcnt(0)
    s_barrier
    ds_read_b128 v[10:13], v9 offset:5632
    s_waitcnt lgkmcnt(0)
    v_and_b32 v208, v10, v4
    v_and_b32 v209, v10, v5
    v_and_b32 v210, v10, v6
    v_and_b32 v211, v10, v7
    v_and_b32 v212, v11, v4
    v_and_b32 v213, v11, v5
    v_and_b32 v214, v11, v6
    v_and_b32 v215, v11, v7
    v_mfma_f32_16x16x32_bf16 v[192:195], v[208:211], v[32:35], 0
    v_and_b32 v216, v12, v4
    v_and_b32 v217, v12, v5
    v_and_b32 v218, v12, v6
    v_and_b32 v219, v12, v7
    v_mfma_f32_16x16x32_bf16 v[192:195], v[212:215], v[36:39], v[192:195]
    v_and_b32 v220, v13, v4
    v_and_b32 v221, v13, v5
    v_and_b32 v222, v13, v6
    v_and_b32 v223, v13, v7
    v_mfma_f32_16x16x32_bf16 v[192:195], v[216:219], v[40:43], v[192:195]
    s_nop 0
    v_mfma_f32_16x16x32_bf16 v[192:195], v[220:223], v[44:47], v[192:195]
    s_lshl_b32 s33, s30, 9
    s_add_u32 s33, s33, 65536
    v_add_u32 v20, s33, v19
    v_add_u32 v22, 3145728, v20
    v_mov_b32 v18, 0
    s_lshl_b32 s33, s28, 12
    s_add_u32 s33, s33, 65536
    v_add_u32 v21, s33, v19
    s_mov_b32 exec_hi, 0
    ds_write_b128 v15, v[192:195] offset:0
    s_mov_b32 s61, 32768
    s_waitcnt lgkmcnt(0)
    s_barrier
    ds_read_b128 v[48:51], v19 offset:0
    ds_read_b128 v[52:55], v19 offset:512
    ds_read_b128 v[56:59], v19 offset:1024
    ds_read_b128 v[60:63], v19 offset:1536
    ds_read_b128 v[64:67], v19 offset:2048
    s_waitcnt lgkmcnt(3)
    v_pk_add_f32 v[48:49], v[48:49], v[52:53]
    v_pk_add_f32 v[50:51], v[50:51], v[54:55]
    s_waitcnt lgkmcnt(1)
    v_pk_add_f32 v[56:57], v[56:57], v[60:61]
    v_pk_add_f32 v[58:59], v[58:59], v[62:63]
    s_waitcnt lgkmcnt(0)
    v_pk_add_f32 v[48:49], v[48:49], v[64:65]
    v_pk_add_f32 v[50:51], v[50:51], v[66:67]
    v_pk_add_f32 v[48:49], v[48:49], v[56:57]
    v_pk_add_f32 v[50:51], v[50:51], v[58:59]
    v_perm_b32 v48, v48, v8, s40
    v_perm_b32 v49, v49, v8, s41
    v_perm_b32 v50, v50, v8, s42
    v_perm_b32 v51, v51, v8, s43
    global_store_dwordx4 v20, v[48:51], s[24:25]
    s_mov_b64 exec, -1
    s_barrier
    global_load_dwordx4 v[68:71], v21, s[24:25] offset:0 sc1
    global_load_dwordx4 v[72:75], v21, s[24:25] offset:1024 sc1
    global_load_dwordx4 v[76:79], v21, s[24:25] offset:2048 sc1
    global_load_dwordx4 v[80:83], v21, s[24:25] offset:3072 sc1
    s_mov_b32 s62, 32768
    v_and_b32 v9, 31, v1
    v_lshrrev_b32 v24, 5, v1
    v_lshlrev_b32 v24, 2, v24
    v_lshl_add_u32 v24, v9, 3, v24
    s_lshr_b32 s55, s32, 8
    s_lshr_b32 s56, s32, 16
    s_lshr_b32 s57, s32, 24
    s_mov_b32 s54, s32

    s_sleep 4
    global_load_dwordx4 v[84:87], v21, s[24:25] offset:0 sc1
    global_load_dwordx4 v[88:91], v21, s[24:25] offset:1024 sc1
    global_load_dwordx4 v[92:95], v21, s[24:25] offset:2048 sc1
    global_load_dwordx4 v[96:99], v21, s[24:25] offset:3072 sc1
    s_sleep 4
    global_load_dwordx4 v[100:103], v21, s[24:25] offset:0 sc1
    global_load_dwordx4 v[104:107], v21, s[24:25] offset:1024 sc1
    global_load_dwordx4 v[108:111], v21, s[24:25] offset:2048 sc1
    global_load_dwordx4 v[112:115], v21, s[24:25] offset:3072 sc1
    s_sleep 4
    global_load_dwordx4 v[116:119], v21, s[24:25] offset:0 sc1
    global_load_dwordx4 v[120:123], v21, s[24:25] offset:1024 sc1
    global_load_dwordx4 v[124:127], v21, s[24:25] offset:2048 sc1
    global_load_dwordx4 v[128:131], v21, s[24:25] offset:3072 sc1
L_qr:
    s_waitcnt vmcnt(14)
    v_bitop3_b32 v28, v68, v72, s54 bitop3:0x7e
    v_bitop3_b32 v29, v69, v73, s55 bitop3:0x7e
    v_bitop3_b32 v30, v70, v74, s56 bitop3:0x7e
    v_bitop3_b32 v31, v71, v75, s57 bitop3:0x7e
    v_or3_b32 v28, v28, v29, v30
    s_waitcnt vmcnt(12)
    v_bitop3_b32 v14, v76, v80, s54 bitop3:0x7e
    v_bitop3_b32 v15, v77, v81, s55 bitop3:0x7e
    v_bitop3_b32 v16, v78, v82, s56 bitop3:0x7e
    v_bitop3_b32 v17, v79, v83, s57 bitop3:0x7e
    v_or3_b32 v28, v28, v31, v14
    v_or3_b32 v15, v15, v16, v17
    v_or_b32 v28, v28, v15
    v_cmp_ne_u32_sdwa vcc, v28, v18 src0_sel:BYTE_0 src1_sel:DWORD
    s_cbranch_vccz L_qok0

    global_load_dwordx4 v[68:71], v21, s[24:25] offset:0 sc1
    global_load_dwordx4 v[72:75], v21, s[24:25] offset:1024 sc1
    global_load_dwordx4 v[76:79], v21, s[24:25] offset:2048 sc1
    global_load_dwordx4 v[80:83], v21, s[24:25] offset:3072 sc1
    s_waitcnt vmcnt(14)
    v_bitop3_b32 v28, v84, v88, s54 bitop3:0x7e
    v_bitop3_b32 v29, v85, v89, s55 bitop3:0x7e
    v_bitop3_b32 v30, v86, v90, s56 bitop3:0x7e
    v_bitop3_b32 v31, v87, v91, s57 bitop3:0x7e
    v_or3_b32 v28, v28, v29, v30
    s_waitcnt vmcnt(12)
    v_bitop3_b32 v14, v92, v96, s54 bitop3:0x7e
    v_bitop3_b32 v15, v93, v97, s55 bitop3:0x7e
    v_bitop3_b32 v16, v94, v98, s56 bitop3:0x7e
    v_bitop3_b32 v17, v95, v99, s57 bitop3:0x7e
    v_or3_b32 v28, v28, v31, v14
    v_or3_b32 v15, v15, v16, v17
    v_or_b32 v28, v28, v15
    v_cmp_ne_u32_sdwa vcc, v28, v18 src0_sel:BYTE_0 src1_sel:DWORD
    s_cbranch_vccz L_qok1

    global_load_dwordx4 v[84:87], v21, s[24:25] offset:0 sc1
    global_load_dwordx4 v[88:91], v21, s[24:25] offset:1024 sc1
    global_load_dwordx4 v[92:95], v21, s[24:25] offset:2048 sc1
    global_load_dwordx4 v[96:99], v21, s[24:25] offset:3072 sc1
    s_waitcnt vmcnt(14)
    v_bitop3_b32 v28, v100, v104, s54 bitop3:0x7e
    v_bitop3_b32 v29, v101, v105, s55 bitop3:0x7e
    v_bitop3_b32 v30, v102, v106, s56 bitop3:0x7e
    v_bitop3_b32 v31, v103, v107, s57 bitop3:0x7e
    v_or3_b32 v28, v28, v29, v30
    s_waitcnt vmcnt(12)
    v_bitop3_b32 v14, v108, v112, s54 bitop3:0x7e
    v_bitop3_b32 v15, v109, v113, s55 bitop3:0x7e
    v_bitop3_b32 v16, v110, v114, s56 bitop3:0x7e
    v_bitop3_b32 v17, v111, v115, s57 bitop3:0x7e
    v_or3_b32 v28, v28, v31, v14
    v_or3_b32 v15, v15, v16, v17
    v_or_b32 v28, v28, v15
    v_cmp_ne_u32_sdwa vcc, v28, v18 src0_sel:BYTE_0 src1_sel:DWORD
    s_cbranch_vccz L_qok2

    global_load_dwordx4 v[100:103], v21, s[24:25] offset:0 sc1
    global_load_dwordx4 v[104:107], v21, s[24:25] offset:1024 sc1
    global_load_dwordx4 v[108:111], v21, s[24:25] offset:2048 sc1
    global_load_dwordx4 v[112:115], v21, s[24:25] offset:3072 sc1
    s_waitcnt vmcnt(14)
    v_bitop3_b32 v28, v116, v120, s54 bitop3:0x7e
    v_bitop3_b32 v29, v117, v121, s55 bitop3:0x7e
    v_bitop3_b32 v30, v118, v122, s56 bitop3:0x7e
    v_bitop3_b32 v31, v119, v123, s57 bitop3:0x7e
    v_or3_b32 v28, v28, v29, v30
    s_waitcnt vmcnt(12)
    v_bitop3_b32 v14, v124, v128, s54 bitop3:0x7e
    v_bitop3_b32 v15, v125, v129, s55 bitop3:0x7e
    v_bitop3_b32 v16, v126, v130, s56 bitop3:0x7e
    v_bitop3_b32 v17, v127, v131, s57 bitop3:0x7e
    v_or3_b32 v28, v28, v31, v14
    v_or3_b32 v15, v15, v16, v17
    v_or_b32 v28, v28, v15
    v_cmp_ne_u32_sdwa vcc, v28, v18 src0_sel:BYTE_0 src1_sel:DWORD
    s_cbranch_vccz L_qok3

    global_load_dwordx4 v[116:119], v21, s[24:25] offset:0 sc1
    global_load_dwordx4 v[120:123], v21, s[24:25] offset:1024 sc1
    global_load_dwordx4 v[124:127], v21, s[24:25] offset:2048 sc1
    global_load_dwordx4 v[128:131], v21, s[24:25] offset:3072 sc1
    s_cmp_eq_u32 s62, 32764
    s_cbranch_scc0 L_qn
    v_add_u32 v21, 3145728, v21
    s_mov_b32 exec_hi, 0
    global_store_dwordx4 v22, v[48:51], s[24:25] sc1
    s_mov_b32 exec_hi, -1
    s_waitcnt vmcnt(0)
L_qn:
    s_sub_u32 s62, s62, 1
    s_cbranch_scc0 L_qr
L_qok0:
    v_pk_add_f32 v[52:53], v[68:69], v[72:73]
    v_pk_add_f32 v[54:55], v[70:71], v[74:75]
    v_pk_add_f32 v[56:57], v[76:77], v[80:81]
    v_pk_add_f32 v[58:59], v[78:79], v[82:83]
    s_branch L_qd
L_qok1:
    v_pk_add_f32 v[52:53], v[84:85], v[88:89]
    v_pk_add_f32 v[54:55], v[86:87], v[90:91]
    v_pk_add_f32 v[56:57], v[92:93], v[96:97]
    v_pk_add_f32 v[58:59], v[94:95], v[98:99]
    s_branch L_qd
L_qok2:
    v_pk_add_f32 v[52:53], v[100:101], v[104:105]
    v_pk_add_f32 v[54:55], v[102:103], v[106:107]
    v_pk_add_f32 v[56:57], v[108:109], v[112:113]
    v_pk_add_f32 v[58:59], v[110:111], v[114:115]
    s_branch L_qd
L_qok3:
    v_pk_add_f32 v[52:53], v[116:117], v[120:121]
    v_pk_add_f32 v[54:55], v[118:119], v[122:123]
    v_pk_add_f32 v[56:57], v[124:125], v[128:129]
    v_pk_add_f32 v[58:59], v[126:127], v[130:131]
L_qd:
    v_pk_add_f32 v[52:53], v[52:53], v[56:57]
    v_pk_add_f32 v[54:55], v[54:55], v[58:59]
    s_nop 1
    v_permlane32_swap_b32 v52, v54
    v_permlane32_swap_b32 v53, v55
    v_pk_add_f32 v[52:53], v[52:53], v[54:55]
    v_cvt_pk_bf16_f32 v10, v52, v53
    ds_write_b32 v24, v10 offset:2560
    s_waitcnt lgkmcnt(0)
    s_barrier
    s_cmp_ge_u32 s46, 2
    s_cselect_b64 s[52:53], -1, 0
    s_mov_b64 exec, s[52:53]
    global_load_dwordx4 v[112:115], v27, s[48:49] nt
    v_add_u32 v27, s50, v27
    global_load_dwordx4 v[116:119], v27, s[48:49] nt
    v_add_u32 v27, s50, v27
    global_load_dwordx4 v[120:123], v27, s[48:49] nt
    v_add_u32 v27, s50, v27
    global_load_dwordx4 v[124:127], v27, s[48:49] nt
    v_add_u32 v27, s50, v27
    global_load_dwordx4 v[128:131], v27, s[48:49] nt
    v_add_u32 v27, s50, v27
    s_mov_b64 exec, -1
    v_mov_b32 v9, 0
    s_lshl_b32 s33, s30, 7
    s_add_u32 s33, s33, 393216
    v_add_u32 v20, s33, v19
    v_add_u32 v23, 3145728, v20
    s_lshl_b32 s33, s30, 9
    s_add_u32 s33, s33, 458752
    v_add_u32 v21, s33, v19
    v_add_u32 v26, 3145728, v21
    v_and_b32 v25, 3, v1
    v_lshlrev_b32 v25, 7, v25
    v_lshl_add_u32 v25, v2, 6, v25
    v_bfe_u32 v24, v1, 2, 2
    v_lshl_add_u32 v25, v24, 4, v25
    s_barrier
    ds_read_b128 v[32:35], v9 offset:2816
    ds_read_b128 v[36:39], v9 offset:2832
    s_waitcnt lgkmcnt(0)
    v_max3_f32 v10, v32, v34, v36
    v_max_f32 v10, v10, v38
    v_sub_f32 v32, v32, v10
    v_sub_f32 v34, v34, v10
    v_sub_f32 v36, v36, v10
    v_sub_f32 v38, v38, v10
    v_mul_f32 v32, 0x3fb8aa3b, v32
    v_mul_f32 v34, 0x3fb8aa3b, v34
    v_mul_f32 v36, 0x3fb8aa3b, v36
    v_mul_f32 v38, 0x3fb8aa3b, v38
    v_exp_f32 v32, v32
    v_exp_f32 v34, v34
    v_exp_f32 v36, v36
    v_exp_f32 v38, v38
    v_mul_f32 v11, v32, v33
    v_fma_f32 v11, v34, v35, v11
    v_fma_f32 v11, v36, v37, v11
    v_fma_f32 v11, v38, v39, v11
    v_xor_b32 v12, v10, v8
    v_xor_b32 v13, v11, v8
    s_mov_b64 exec, 0xff
    global_store_dwordx4 v20, v[10:13], s[24:25]

    s_mov_b32 exec_lo, -1
    s_barrier

    ds_read_b128 v[52:55], v25 offset:3072
    ds_read_b128 v[56:59], v25 offset:3584
    ds_read_b128 v[60:63], v25 offset:4096
    ds_read_b128 v[64:67], v25 offset:4608
    s_waitcnt lgkmcnt(3)
    v_pk_mul_f32 v[52:53], v[52:53], v[32:33] op_sel_hi:[1,0]
    v_pk_mul_f32 v[54:55], v[54:55], v[32:33] op_sel_hi:[1,0]
    s_waitcnt lgkmcnt(2)
    v_pk_fma_f32 v[52:53], v[56:57], v[34:35], v[52:53] op_sel_hi:[1,0,1]
    v_pk_fma_f32 v[54:55], v[58:59], v[34:35], v[54:55] op_sel_hi:[1,0,1]
    s_waitcnt lgkmcnt(1)
    v_pk_fma_f32 v[52:53], v[60:61], v[36:37], v[52:53] op_sel_hi:[1,0,1]
    v_pk_fma_f32 v[54:55], v[62:63], v[36:37], v[54:55] op_sel_hi:[1,0,1]
    s_waitcnt lgkmcnt(0)
    v_pk_fma_f32 v[52:53], v[64:65], v[38:39], v[52:53] op_sel_hi:[1,0,1]
    v_pk_fma_f32 v[54:55], v[66:67], v[38:39], v[54:55] op_sel_hi:[1,0,1]
    v_perm_b32 v52, v52, v8, s40
    v_perm_b32 v53, v53, v8, s41
    v_perm_b32 v54, v54, v8, s42
    v_perm_b32 v55, v55, v8, s43
    global_store_dwordx4 v21, v[52:55], s[24:25]
    s_mov_b64 exec, -1
    s_barrier
    s_mov_b64 exec, s[52:53]
    global_load_dwordx4 v[132:135], v27, s[48:49] nt
    v_add_u32 v27, s50, v27
    global_load_dwordx4 v[136:139], v27, s[48:49] nt
    v_add_u32 v27, s50, v27
    global_load_dwordx4 v[140:143], v27, s[48:49] nt
    s_mov_b64 exec, -1
    s_mov_b32 exec_lo, -1
    s_mov_b32 exec_hi, 0
    global_store_dwordx4 v22, v[48:51], s[24:25] sc1
    global_store_dwordx4 v26, v[52:55], s[24:25] sc1
    s_mov_b32 exec_lo, 0xff
    global_store_dwordx4 v23, v[10:13], s[24:25] sc1
    s_mov_b64 exec, -1

    s_cmp_eq_u32 s46, 2
    s_cbranch_scc1 L_ffn
    s_cmp_lg_u32 s46, 1
    s_cbranch_scc1 L_fin

    s_mul_i32 s33, s26, 2560
    s_lshl_b32 s34, s47, 7
    s_add_u32 s33, s33, s34
    s_add_u32 s33, s33, 1048576
    v_and_b32 v9, 0x70, v19
    v_lshrrev_b32 v21, 3, v1
    v_lshl_add_u32 v21, v21, 16, v9
    v_add_u32 v21, s33, v21
    v_add_u32 v22, 32768, v21
    s_mov_b32 exec_lo, 65535
    s_mov_b32 exec_hi, 0
    v_lshrrev_b32 v14, 3, v1
    v_lshl_add_u32 v9, v14, 9, v9
    s_barrier
    ds_read_b128 v[32:35], v9 offset:0
    ds_read_b128 v[36:39], v9 offset:128
    ds_read_b128 v[40:43], v9 offset:256
    ds_read_b128 v[44:47], v9 offset:384
    s_waitcnt lgkmcnt(2)
    v_pk_add_f32 v[32:33], v[32:33], v[36:37]
    v_pk_add_f32 v[34:35], v[34:35], v[38:39]
    s_waitcnt lgkmcnt(1)
    v_pk_add_f32 v[32:33], v[32:33], v[40:41]
    v_pk_add_f32 v[34:35], v[34:35], v[42:43]
    s_waitcnt lgkmcnt(0)
    v_pk_add_f32 v[32:33], v[32:33], v[44:45]
    v_pk_add_f32 v[34:35], v[34:35], v[46:47]
    s_nop 0
    v_add_f32_dpp v32, v32, v32 row_ror:8 row_mask:0xf bank_mask:0xf
    v_add_f32_dpp v33, v33, v33 row_ror:8 row_mask:0xf bank_mask:0xf
    v_add_f32_dpp v34, v34, v34 row_ror:8 row_mask:0xf bank_mask:0xf
    v_add_f32_dpp v35, v35, v35 row_ror:8 row_mask:0xf bank_mask:0xf
    v_perm_b32 v32, v32, v8, s40
    v_perm_b32 v33, v33, v8, s41
    v_perm_b32 v34, v34, v8, s42
    v_perm_b32 v35, v35, v8, s43
    global_store_dwordx4 v21, v[32:35], s[24:25] sc1
    global_store_dwordx4 v22, v[32:35], s[24:25]
    s_branch L_fin
L_ffn:
    s_mul_i32 s33, s31, 9216
    s_add_u32 s33, s33, 8192
    v_lshl_add_u32 v20, v1, 4, s33
    v_xor_b32 v21, 32, v20
    v_lshrrev_b32 v25, 2, v3
    v_and_b32 v9, 3, v3
    v_lshlrev_b32 v22, 10, v2
    v_lshl_add_u32 v22, v25, 6, v22
    v_lshl_add_u32 v22, v9, 3, v22
    v_and_b32 v24, 1, v2
    v_lshl_add_u32 v22, v24, 5, v22
    v_add_u32 v22, s33, v22
    v_xor_b32 v23, 32, v22
    v_lshlrev_b32 v24, 6, v2
    v_lshl_add_u32 v24, v9, 4, v24

    s_lshl_b32 s33, s47, 5
    v_add_u32 v26, s33, v2
    v_mul_u32_u24 v26, 1280, v26
    v_lshl_add_u32 v26, v3, 4, v26
    s_lshl_b32 s33, s31, 8
    v_add_u32 v26, s33, v26
    v_lshrrev_b32 v9, 1, v24
    v_add_u32 v9, s33, v9
    s_waitcnt vmcnt(7)
    global_load_dwordx4 v[144:147], v26, s[18:19] nt
    v_add_u32 v26, 5120, v26
    ds_write_b128 v20, v[112:115] offset:0
    s_waitcnt vmcnt(7)
    global_load_dwordx4 v[148:151], v26, s[18:19] nt
    v_add_u32 v26, 5120, v26
    ds_write_b128 v21, v[116:119] offset:1024
    s_waitcnt vmcnt(7)
    global_load_dwordx4 v[152:155], v26, s[18:19] nt
    v_add_u32 v26, 5120, v26
    ds_write_b128 v20, v[120:123] offset:2048
    s_waitcnt vmcnt(7)
    global_load_dwordx4 v[156:159], v26, s[18:19] nt
    v_add_u32 v26, 5120, v26
    ds_write_b128 v21, v[124:127] offset:3072
    s_waitcnt vmcnt(7)
    global_load_dwordx4 v[160:163], v26, s[18:19] nt
    v_add_u32 v26, 5120, v26
    ds_write_b128 v20, v[128:131] offset:4096
    s_waitcnt vmcnt(7)
    global_load_dwordx4 v[164:167], v26, s[18:19] nt
    v_add_u32 v26, 5120, v26
    ds_write_b128 v21, v[132:135] offset:5120
    s_waitcnt vmcnt(7)
    global_load_dwordx4 v[168:171], v26, s[18:19] nt
    v_add_u32 v26, 5120, v26
    ds_write_b128 v20, v[136:139] offset:6144
    s_waitcnt vmcnt(7)
    global_load_dwordx4 v[172:175], v26, s[18:19] nt
    ds_write_b128 v21, v[140:143] offset:7168
    global_load_dwordx2 v[16:17], v9, s[4:5]
    global_load_dwordx2 v[18:19], v9, s[4:5] offset:128
    v_mul_u32_u24 v27, 5120, v25
    v_add_u32 v27, v27, v24
    s_lshl_b32 s33, s31, 9
    s_add_u32 s34, s33, 1048576
    v_add_u32 v27, s34, v27
    v_add_u32 v31, 2560, v27
    v_mov_b32 v48, 0x3f803f80
    v_mov_b32 v49, 0x3f803f80
    v_mov_b32 v50, 0x3f803f80
    v_mov_b32 v51, 0x3f803f80
    s_mul_i32 s35, s26, 2560
    s_add_u32 s35, s35, 1048576
    s_movk_i32 s36, 2560
    v_mov_b32 v12, 32768
    v_subrev_u32 v9, s35, v27
    v_cmp_gt_u32 vcc, s36, v9
    s_nop 1
    v_cndmask_b32 v9, 0, v12, vcc
    v_add_u32 v27, v27, v9
    v_subrev_u32 v9, s35, v31
    v_cmp_gt_u32 vcc, s36, v9
    s_nop 1
    v_cndmask_b32 v9, 0, v12, vcc
    v_add_u32 v31, v31, v9
    v_mov_b32 v26, v31
    s_add_u32 s38, s24, 65536
    s_addc_u32 s39, s25, 0
    s_add_u32 s48, s24, 131072
    s_addc_u32 s49, s25, 0
    s_add_u32 s50, s24, 196608
    s_addc_u32 s51, s25, 0
    s_waitcnt lgkmcnt(0)
    ds_read_b64_tr_b16 v[112:113], v22 offset:0
    ds_read_b64_tr_b16 v[114:115], v22 offset:4096
    ds_read_b64_tr_b16 v[116:117], v22 offset:256
    ds_read_b64_tr_b16 v[118:119], v22 offset:4352
    ds_read_b64_tr_b16 v[120:121], v22 offset:512
    ds_read_b64_tr_b16 v[122:123], v22 offset:4608
    ds_read_b64_tr_b16 v[124:125], v22 offset:768
    ds_read_b64_tr_b16 v[126:127], v22 offset:4864
    ds_read_b64_tr_b16 v[128:129], v23 offset:0
    ds_read_b64_tr_b16 v[130:131], v23 offset:4096
    ds_read_b64_tr_b16 v[132:133], v23 offset:256
    ds_read_b64_tr_b16 v[134:135], v23 offset:4352
    ds_read_b64_tr_b16 v[136:137], v23 offset:512
    ds_read_b64_tr_b16 v[138:139], v23 offset:4608
    ds_read_b64_tr_b16 v[140:141], v23 offset:768
    ds_read_b64_tr_b16 v[142:143], v23 offset:4864
    s_mul_i32 s34, s31, 9216
    s_add_u32 s34, s34, 8192
    v_mul_u32_u24 v20, 288, v2
    v_lshl_add_u32 v20, v3, 4, v20
    v_add_u32 v20, s34, v20
    v_lshl_add_u32 v21, v2, 2, v25
    v_mul_u32_u24 v21, 288, v21
    v_and_b32 v9, 3, v3
    v_lshl_add_u32 v21, v9, 3, v21
    v_add_u32 v21, s34, v21
    v_lshlrev_b32 v15, 2, v1
    s_waitcnt lgkmcnt(0)
    v_mfma_f32_16x16x32_bf16 v[176:179], v[48:51], v[112:115], 0
    v_mfma_f32_16x16x32_bf16 v[180:183], v[48:51], v[128:131], 0
    v_mfma_f32_16x16x32_bf16 v[176:179], v[48:51], v[116:119], v[176:179]
    v_mfma_f32_16x16x32_bf16 v[180:183], v[48:51], v[132:135], v[180:183]
    v_mfma_f32_16x16x32_bf16 v[176:179], v[48:51], v[120:123], v[176:179]
    v_mfma_f32_16x16x32_bf16 v[180:183], v[48:51], v[136:139], v[180:183]
    v_mfma_f32_16x16x32_bf16 v[176:179], v[48:51], v[124:127], v[176:179]
    v_mfma_f32_16x16x32_bf16 v[180:183], v[48:51], v[140:143], v[180:183]
    s_nop 7
    v_mov_b32_dpp v176, v180 quad_perm:[0,1,2,3] row_mask:0x2 bank_mask:0xf
    s_mov_b32 exec_hi, 0
    ds_add_f32 v15, v176 offset:5376
    s_mov_b32 exec_hi, -1
    s_waitcnt vmcnt(9)
    ds_write_b128 v20, v[144:147] offset:0
    s_waitcnt vmcnt(8)
    ds_write_b128 v20, v[148:151] offset:1152
    s_waitcnt vmcnt(7)
    ds_write_b128 v20, v[152:155] offset:2304
    s_waitcnt vmcnt(6)
    ds_write_b128 v20, v[156:159] offset:3456
    s_waitcnt vmcnt(5)
    ds_write_b128 v20, v[160:163] offset:4608
    s_waitcnt vmcnt(4)
    ds_write_b128 v20, v[164:167] offset:5760
    s_waitcnt vmcnt(3)
    ds_write_b128 v20, v[168:171] offset:6912
    s_waitcnt vmcnt(2)
    global_load_dwordx4 v[32:35], v27, s[24:25] offset:0 sc1
    global_load_dwordx4 v[36:39], v27, s[24:25] offset:256 sc1
    global_load_dwordx4 v[40:43], v26, s[24:25] offset:0 sc1
    global_load_dwordx4 v[44:47], v26, s[24:25] offset:256 sc1
    ds_write_b128 v20, v[172:175] offset:8064
    s_waitcnt lgkmcnt(0)
    ds_read_b64_tr_b16 v[144:145], v21 offset:0
    ds_read_b64_tr_b16 v[146:147], v21 offset:4608
    ds_read_b64_tr_b16 v[148:149], v21 offset:32
    ds_read_b64_tr_b16 v[150:151], v21 offset:4640
    ds_read_b64_tr_b16 v[152:153], v21 offset:64
    ds_read_b64_tr_b16 v[154:155], v21 offset:4672
    ds_read_b64_tr_b16 v[156:157], v21 offset:96
    ds_read_b64_tr_b16 v[158:159], v21 offset:4704
    ds_read_b64_tr_b16 v[160:161], v21 offset:128
    ds_read_b64_tr_b16 v[162:163], v21 offset:4736
    ds_read_b64_tr_b16 v[164:165], v21 offset:160
    ds_read_b64_tr_b16 v[166:167], v21 offset:4768
    ds_read_b64_tr_b16 v[168:169], v21 offset:192
    ds_read_b64_tr_b16 v[170:171], v21 offset:4800
    ds_read_b64_tr_b16 v[172:173], v21 offset:224
    ds_read_b64_tr_b16 v[174:175], v21 offset:4832
    s_waitcnt vmcnt(4)
    s_mov_b32 s36, 983055
    s_mov_b32 s37, s36
    s_mov_b32 s38, 15728880
    s_mov_b32 s39, s38
    s_mov_b32 s48, 251662080
    s_mov_b32 s49, s48
    s_mov_b32 s50, 4026593280
    s_mov_b32 s51, s50
    v_cndmask_b32 v16, v16, v17, s[38:39]
    v_cndmask_b32 v16, v16, v18, s[48:49]
    v_cndmask_b32 v16, v16, v19, s[50:51]
    v_lshlrev_b32 v80, 16, v16
    v_and_b32 v81, 0xffff0000, v16
    v_lshlrev_b32 v22, 4, v2
    v_mov_b32 v9, 128
    s_nop 1
    v_mov_b32_dpp v15, v9 quad_perm:[0,1,2,3] row_mask:0x4 bank_mask:0xf
    v_mov_b32 v9, 132
    s_nop 1
    v_mov_b32_dpp v15, v9 quad_perm:[0,1,2,3] row_mask:0x8 bank_mask:0xf
    s_mul_i32 s34, s47, 2560
    s_add_u32 s34, s34, s33
    s_add_u32 s34, s34, 4194304
    v_lshl_add_u32 v23, v3, 4, s34
    v_mul_u32_u24 v9, 147456, v2
    v_add_u32 v23, v23, v9
    v_mov_b32 v9, 0
    v_lshl_add_u32 v23, v1, 4, s34
    v_and_b32 v15, 31, v1
    v_lshlrev_b32 v15, 2, v15
    v_bfe_u32 v17, v1, 3, 1
    v_lshlrev_b32 v17, 2, v17

    v_and_b32 v10, 7, v1
    v_lshl_add_u32 v17, v10, 3, v17
    v_and_b32 v10, 0x30, v1
    v_lshl_add_u32 v17, v10, 2, v17
    s_nop 1
    v_mov_b32_dpp v15, v17 quad_perm:[0,1,2,3] row_mask:0xc bank_mask:0xf
    s_lshl_b32 s35, s31, 8
    v_add_u32 v15, s35, v15
    v_and_b32 v10, 1, v1
    v_lshl_add_u32 v22, v10, 3, v22
    v_and_b32 v10, 2, v1
    v_lshl_add_u32 v22, v10, 5, v22
    v_add_u32 v22, 3840, v22
    v_add_u32 v15, 3840, v15
    v_mov_b32 v9, 3840

    v_add_u32 v21, 1048576, v23
    s_mov_b32 s62, 32768
L_w:
    s_waitcnt vmcnt(3)
    v_perm_b32 v28, v33, v32, s44
    v_perm_b32 v29, v35, v34, s45
    v_or_b32 v28, v28, v29
    v_cmp_ne_u32 s[54:55], v28, v8
    s_waitcnt vmcnt(2)
    v_perm_b32 v30, v37, v36, s44
    v_perm_b32 v31, v39, v38, s45
    v_or_b32 v30, v30, v31
    v_cmp_ne_u32 s[56:57], v30, v8
    s_or_b64 s[34:35], s[54:55], s[56:57]
    s_waitcnt vmcnt(1)
    v_perm_b32 v28, v41, v40, s44
    v_perm_b32 v29, v43, v42, s45
    v_or_b32 v28, v28, v29
    v_cmp_ne_u32 s[58:59], v28, v8
    s_or_b64 s[34:35], s[34:35], s[58:59]
    s_waitcnt vmcnt(0)
    v_perm_b32 v30, v45, v44, s44
    v_perm_b32 v31, v47, v46, s45
    v_or_b32 v30, v30, v31
    v_cmp_ne_u32 s[60:61], v30, v8
    v_pk_add_f32 v[68:69], v[32:33], v[40:41]
    v_pk_add_f32 v[70:71], v[34:35], v[42:43]
    v_pk_add_f32 v[72:73], v[36:37], v[44:45]
    v_pk_add_f32 v[74:75], v[38:39], v[46:47]
    s_or_b64 s[34:35], s[34:35], s[60:61]
    s_cbranch_scc0 L_w_ok0
    s_mov_b64 exec, s[54:55]
    global_load_dwordx4 v[32:35], v27, s[24:25] offset:0 sc1
    s_mov_b64 exec, s[56:57]
    global_load_dwordx4 v[36:39], v27, s[24:25] offset:256 sc1
    s_mov_b64 exec, s[58:59]
    global_load_dwordx4 v[40:43], v26, s[24:25] offset:0 sc1
    s_mov_b64 exec, s[60:61]
    global_load_dwordx4 v[44:47], v26, s[24:25] offset:256 sc1
    s_mov_b64 exec, -1
    s_cmp_gt_u32 s62, 32720
    s_cselect_b32 s33, -1, 4294934527
    v_and_b32 v26, s33, v26
    v_and_b32 v27, s33, v27
    s_sub_u32 s62, s62, 1
    s_cbranch_scc0 L_w
L_w_ok0:
    v_add_f32_dpp v70, v70, v70 row_ror:8 row_mask:0xf bank_mask:0x3
    v_add_f32_dpp v71, v71, v71 row_ror:8 row_mask:0xf bank_mask:0x3
    v_add_f32_dpp v68, v68, v68 row_ror:8 row_mask:0xf bank_mask:0x3
    v_add_f32_dpp v69, v69, v69 row_ror:8 row_mask:0xf bank_mask:0x3
    v_add_f32_dpp v70, v74, v74 row_ror:8 row_mask:0xf bank_mask:0xc
    v_add_f32_dpp v71, v75, v75 row_ror:8 row_mask:0xf bank_mask:0xc
    v_add_f32_dpp v68, v72, v72 row_ror:8 row_mask:0xf bank_mask:0xc
    v_add_f32_dpp v69, v73, v73 row_ror:8 row_mask:0xf bank_mask:0xc
    v_add_f32_dpp v72, v70, v70 row_shr:4 row_mask:0xf bank_mask:0xa
    v_add_f32_dpp v73, v71, v71 row_shr:4 row_mask:0xf bank_mask:0xa
    s_nop 0
    v_add_f32_dpp v72, v68, v68 row_shl:4 row_mask:0xf bank_mask:0x5
    v_add_f32_dpp v73, v69, v69 row_shl:4 row_mask:0xf bank_mask:0x5
    v_cvt_pk_bf16_f32 v68, v72, v73
    v_lshlrev_b32 v70, 16, v68
    v_and_b32 v71, 0xffff0000, v68
    v_pk_add_f32 v[70:71], v[70:71], v[80:81]
    v_cvt_pk_bf16_f32 v68, v70, v71
    v_cndmask_b32 v76, 0, v68, s[36:37]
    v_cndmask_b32 v77, 0, v68, s[38:39]
    v_cndmask_b32 v78, 0, v68, s[48:49]
    v_cndmask_b32 v79, 0, v68, s[50:51]
    v_lshlrev_b32 v70, 16, v68
    v_and_b32 v71, 0xffff0000, v68
    v_mfma_f32_16x16x32_bf16 v[176:179], v[76:79], v[112:115], 0
    v_add_f32 v12, v70, v71
    v_mul_f32 v13, v70, v70
    v_mfma_f32_16x16x32_bf16 v[180:183], v[76:79], v[116:119], 0
    v_fma_f32 v13, v71, v71, v13
    v_mfma_f32_16x16x32_bf16 v[184:187], v[76:79], v[120:123], 0
    v_add_f32_dpp v14, v12, v12 row_ror:8 row_mask:0xf bank_mask:0x3
    v_mfma_f32_16x16x32_bf16 v[188:191], v[76:79], v[124:127], 0
    s_nop 0
    v_add_f32_dpp v14, v13, v13 row_ror:8 row_mask:0xf bank_mask:0xc
    v_mfma_f32_16x16x32_bf16 v[192:195], v[76:79], v[128:131], 0
    v_mfma_f32_16x16x32_bf16 v[196:199], v[76:79], v[132:135], 0
    v_add_f32_dpp v14, v14, v14 row_half_mirror row_mask:0xf bank_mask:0xf
    v_mfma_f32_16x16x32_bf16 v[200:203], v[76:79], v[136:139], 0
    v_add_f32 v10, v176, v181
    v_mfma_f32_16x16x32_bf16 v[204:207], v[76:79], v[140:143], 0
    v_add_f32_dpp v14, v14, v14 quad_perm:[1,0,3,2] row_mask:0xf bank_mask:0xf
    v_add_f32 v11, v186, v191
    v_add_f32 v10, v10, v11
    v_add_f32_dpp v14, v14, v14 quad_perm:[2,3,0,1] row_mask:0xf bank_mask:0xf
    v_add_f32 v12, v192, v197
    v_mov_b32 v11, v14
    s_nop 1
    v_add_f32 v13, v202, v207
    v_add_f32 v12, v12, v13
    v_permlane16_swap_b32 v14, v11
    v_add_f32 v14, v14, v11
    v_permlane16_swap_b32 v10, v12
    v_add_f32 v10, v10, v12
    s_nop 1
    v_permlane32_swap_b32 v10, v14
    v_add_f32 v10, v10, v14
    ds_write_b32 v15, v10 offset:0
    s_waitcnt lgkmcnt(0)
    s_barrier
    ds_read2_b64 v[96:99], v9 offset0:16 offset1:48
    ds_read2_b64 v[100:103], v9 offset0:80 offset1:112
    ds_read_b64 v[10:11], v9 offset:1152
    ds_read2_b64 v[68:71], v22 offset0:0 offset1:32
    ds_read2_b64 v[72:75], v22 offset0:64 offset1:96
    ds_read2_b64 v[104:107], v22 offset0:128 offset1:192
    s_waitcnt lgkmcnt(5)
    v_pk_add_f32 v[96:97], v[96:97], v[98:99]
    s_waitcnt lgkmcnt(4)
    v_pk_add_f32 v[100:101], v[100:101], v[102:103]
    s_waitcnt lgkmcnt(3)
    v_pk_add_f32 v[10:11], v[10:11], v[96:97]
    v_pk_add_f32 v[10:11], v[10:11], v[100:101]
    v_mul_f32 v10, 0x3acccccd, v10
    s_waitcnt lgkmcnt(2)
    v_pk_add_f32 v[68:69], v[68:69], v[70:71]
    v_cvt_pk_bf16_f32 v12, v10, v10
    s_waitcnt lgkmcnt(1)
    v_pk_add_f32 v[72:73], v[72:73], v[74:75]
    v_lshlrev_b32 v12, 16, v12
    s_waitcnt lgkmcnt(0)
    v_pk_add_f32 v[68:69], v[68:69], v[104:105]
    v_pk_fma_f32 v[72:73], v[106:107], v[12:13], v[72:73] op_sel_hi:[1,0,1] neg_lo:[1,0,0] neg_hi:[1,0,0]
    v_pk_add_f32 v[68:69], v[68:69], v[72:73]
    v_cvt_pk_bf16_f32 v68, v68, v69
    v_pk_max_i16 v68, v68, 0
    v_mul_f32 v11, 0x3acccccd, v11
    v_fma_f32 v11, -v10, v10, v11

    v_mov_b32_dpp v76, v68 quad_perm:[0,0,0,0] row_mask:0xf bank_mask:0xf
    v_mov_b32_dpp v77, v68 quad_perm:[1,1,1,1] row_mask:0xf bank_mask:0xf
    v_mov_b32_dpp v78, v68 quad_perm:[2,2,2,2] row_mask:0xf bank_mask:0xf
    v_mov_b32_dpp v79, v68 quad_perm:[3,3,3,3] row_mask:0xf bank_mask:0xf
    v_max_f32 v11, 0, v11
    v_cvt_pk_bf16_f32 v13, v11, v11
    v_mfma_f32_16x16x32_bf16 v[176:179], v[76:79], v[144:147], 0
    v_lshlrev_b32 v13, 16, v13
    v_mfma_f32_16x16x32_bf16 v[180:183], v[76:79], v[148:151], 0
    v_add_f32 v13, 0x3727c5ac, v13
    v_mfma_f32_16x16x32_bf16 v[184:187], v[76:79], v[152:155], 0
    v_cvt_pk_bf16_f32 v13, v13, v13
    v_mfma_f32_16x16x32_bf16 v[188:191], v[76:79], v[156:159], 0
    v_lshlrev_b32 v13, 16, v13
    v_mfma_f32_16x16x32_bf16 v[192:195], v[76:79], v[160:163], 0
    v_sqrt_f32 v13, v13
    v_mfma_f32_16x16x32_bf16 v[196:199], v[76:79], v[164:167], 0
    v_cvt_pk_bf16_f32 v13, v13, v13
    v_mfma_f32_16x16x32_bf16 v[200:203], v[76:79], v[168:171], 0
    v_lshlrev_b32 v13, 16, v13
    v_mfma_f32_16x16x32_bf16 v[204:207], v[76:79], v[172:175], 0
    v_rcp_f32 v14, v13
    s_mov_b32 exec_hi, 0
    s_nop 0
    v_mul_f32_dpp v68, v176, v14 quad_perm:[0,1,2,3] row_mask:1 bank_mask:0xf
    v_mul_f32_dpp v69, v180, v14 quad_perm:[0,1,2,3] row_mask:1 bank_mask:0xf
    v_mul_f32_dpp v70, v184, v14 quad_perm:[0,1,2,3] row_mask:1 bank_mask:0xf
    v_mul_f32_dpp v71, v188, v14 quad_perm:[0,1,2,3] row_mask:1 bank_mask:0xf
    v_mul_f32_dpp v68, v192, v14 quad_perm:[0,1,2,3] row_mask:2 bank_mask:0xf
    v_mul_f32_dpp v69, v196, v14 quad_perm:[0,1,2,3] row_mask:2 bank_mask:0xf
    v_mul_f32_dpp v70, v200, v14 quad_perm:[0,1,2,3] row_mask:2 bank_mask:0xf
    v_mul_f32_dpp v71, v204, v14 quad_perm:[0,1,2,3] row_mask:2 bank_mask:0xf
    v_perm_b32 v68, v68, v8, s40
    v_perm_b32 v69, v69, v8, s41
    v_perm_b32 v70, v70, v8, s42
    v_perm_b32 v71, v71, v8, s43

    global_store_dwordx4 v23, v[68:71], s[24:25] sc1
    global_store_dwordx4 v21, v[68:71], s[24:25]
L_fin:
L_end:
    s_endpgm
L_last:
    s_nop 0
.section .rodata,"a"
.p2align 6
.amdhsa_kernel sequential_preLN__sliding_block_cached__dense_activation_relu__decode_kernel
  .amdhsa_next_free_vgpr 240
  .amdhsa_next_free_sgpr 102
  .amdhsa_accum_offset 240
  .amdhsa_group_segment_fixed_size 0
  .amdhsa_kernarg_size 88
  .amdhsa_user_sgpr_count 2
  .amdhsa_user_sgpr_kernarg_segment_ptr 1
  .amdhsa_system_sgpr_workgroup_id_x 1
  .amdhsa_float_denorm_mode_32 3
.end_amdhsa_kernel
```
